```python
import torch

def _softmax(x, axis=-1):
    return torch.softmax(x, dim=axis)
def _gelu(x):
    return torch.nn.functional.gelu(x, approximate="tanh")
def _silu(x):
    return torch.nn.functional.silu(x)
def _sigmoid(x):
    return torch.sigmoid(x)
def _layernorm(x, axis=-1, eps=1e-5):
    m = x.mean(dim=axis, keepdim=True)
    v = x.var(dim=axis, keepdim=True, unbiased=False)
    return (x - m) / torch.sqrt(v + eps)
def _scatter_add(tgt, idx, src, axis=0):
    return tgt.clone().index_add_(axis, idx, src)
def _segment_sum(src, seg, n):
    out = torch.zeros((n,) + src.shape[1:], dtype=src.dtype)
    return out.index_add_(0, seg, src)
def _pad(x, pw):
    flat = tuple(v for pair in reversed(pw) for v in pair)
    return torch.nn.functional.pad(x, flat)

kernel_name = 'standalone__low_rank_proj_linformer__prompt'

def setup_inputs():

    _w = (lambda a: (lambda t: t.to(torch.bfloat16) if t.is_floating_point() else t)(torch.as_tensor(a)))
    B, H, Sq, Skv, Dh, R = 1, 32, 2048, 2048, 192, 8
    return {
        "q": _w((lambda *s: torch.randn(*s, dtype=torch.bfloat16) * 0.8)(B, H, Sq, Dh)),
        "k": _w((lambda *s: torch.randn(*s, dtype=torch.bfloat16) * 0.8)(B, H, Skv, Dh)),
        "v": _w((lambda *s: torch.randn(*s, dtype=torch.bfloat16) * 0.05)(B, H, Skv, Dh)),
        "e_proj": _w((lambda *s: torch.randn(*s, dtype=torch.bfloat16) * 0.8)(R, Skv) * (Skv ** -0.5)),
        "f_proj": _w((lambda *s: torch.randn(*s, dtype=torch.bfloat16) * 0.05)(R, Skv) * (Skv ** -0.5)),
    }

def reference(q, k, v, e_proj, f_proj):
    B, H, Sq, Dh = q.shape
    kp = torch.einsum("rn,bhnd->bhrd", e_proj, k)
    vp = torch.einsum("rn,bhnd->bhrd", f_proj, v)
    scores = torch.einsum("bhqd,bhrd->bhqr", q, kp) * (Dh ** -0.5)
    p = _softmax(scores, axis=-1)
    o = torch.einsum("bhqr,bhrd->bhqd", p, vp)
    return o
```

```asm
; @launch grid=(256,1,1) block=(512,1,1) lds=154624
.amdgcn_target "amdgcn-amd-amdhsa--gfx950"
.text
.globl standalone__low_rank_proj_linformer__prompt_kernel
.p2align 8
.type standalone__low_rank_proj_linformer__prompt_kernel,@function
standalone__low_rank_proj_linformer__prompt_kernel:
    s_cmp_ge_u32 s2, 256
    s_cbranch_scc1 L_end
    s_load_dwordx16 s[4:19], s[0:1], 0
    s_setprio 2
    v_lshrrev_b32 v2, 6, v0
    v_and_b32 v1, 63, v0
    v_nop
    v_readfirstlane_b32 s44, v2
    s_and_b32 s40, s2, 7
    s_lshr_b32 s41, s2, 3
    s_and_b32 s41, s41, 3
    s_lshl_b32 s40, s40, 2
    s_add_u32 s40, s40, s41
    s_lshr_b32 s41, s2, 5
    s_lshr_b32 s42, s41, 2
    s_and_b32 s43, s41, 3
    s_lshl_b32 s45, s40, 3
    s_add_u32 s45, s45, s41
    s_lshl_b32 s51, s40, 2
    s_add_u32 s51, s51, s43
    s_mul_i32 s51, s51, 196608
    s_mul_i32 s53, s44, 24576
    s_add_u32 s46, s53, 0
    s_add_u32 s47, s53, 6144
    s_add_u32 s48, s53, 12288
    s_add_u32 s49, s53, 18432
    s_lshl_b32 s50, s43, 10
    s_lshl_b32 s54, s44, 7
    s_add_u32 s50, s50, s54
    s_mul_i32 s64, s45, 6144
    v_lshrrev_b32 v4, 5, v1
    v_and_b32 v5, 31, v1
    v_mul_u32_u24 v4, 3072, v4
    v_mul_u32_u24 v5, 12, v5
    v_add_u32 v2, v4, v5
    v_lshrrev_b32 v6, 4, v1
    v_and_b32 v7, 15, v1
    v_and_b32 v4, 7, v1
    v_lshlrev_b32 v4, 12, v4
    v_lshrrev_b32 v5, 5, v1
    v_lshl_add_u32 v3, v5, 4, v4
    v_lshrrev_b32 v4, 3, v1
    v_xor_b32 v4, v4, v6
    v_and_b32 v4, 1, v4
    v_lshlrev_b32 v4, 30, v4
    v_or_b32 v3, v3, v4
    v_lshlrev_b32 v85, 4, v1
    v_mov_b32 v88, -1
    v_mov_b32 v89, -1
    v_mov_b32 v90, -1
    v_mov_b32 v91, -1
    s_waitcnt lgkmcnt(0)
    s_cmp_eq_u32 s42, 0
    s_cselect_b32 s20, s6, s8
    s_cselect_b32 s21, s7, s9
    s_cselect_b32 s24, s10, s12
    s_cselect_b32 s25, s11, s13
    s_add_u32 s20, s20, s51
    s_addc_u32 s21, s21, 0
    s_mov_b32 s22, 196608
    s_mov_b32 s23, 0x20000
    s_mov_b32 s26, 32768
    s_mov_b32 s27, 0x20000
    s_mov_b32 s36, s18
    s_mov_b32 s37, s19
    s_mov_b32 s38, 1572864
    s_mov_b32 s39, 0x20000
    s_cmp_lg_u32 s44, 0
    s_cbranch_scc1 L_noclear
    s_add_u32 s65, s64, 4096
    buffer_store_dwordx4 v[88:91], v85, s[36:39], s64 offen offset:0 sc1
    buffer_store_dwordx4 v[88:91], v85, s[36:39], s64 offen offset:1024 sc1
    buffer_store_dwordx4 v[88:91], v85, s[36:39], s64 offen offset:2048 sc1
    buffer_store_dwordx4 v[88:91], v85, s[36:39], s64 offen offset:3072 sc1
    buffer_store_dwordx4 v[88:91], v85, s[36:39], s65 offen offset:0 sc1
    buffer_store_dwordx4 v[88:91], v85, s[36:39], s65 offen offset:1024 sc1
L_noclear:
    buffer_load_dwordx4 v[8:11], v3, s[24:27], s50 offen offset:0
    buffer_load_dwordx4 v[12:15], v3, s[24:27], s50 offen offset:32
    buffer_load_dwordx4 v[16:19], v3, s[24:27], s50 offen offset:64
    buffer_load_dwordx4 v[20:23], v3, s[24:27], s50 offen offset:96
    buffer_load_dwordx3 v[128:130], v2, s[20:23], s46 offen offset:0 nt
    buffer_load_dwordx3 v[132:134], v2, s[20:23], s46 offen offset:384 nt
    buffer_load_dwordx3 v[136:138], v2, s[20:23], s46 offen offset:768 nt
    buffer_load_dwordx3 v[140:142], v2, s[20:23], s46 offen offset:1152 nt
    buffer_load_dwordx3 v[144:146], v2, s[20:23], s46 offen offset:1536 nt
    buffer_load_dwordx3 v[148:150], v2, s[20:23], s46 offen offset:1920 nt
    buffer_load_dwordx3 v[152:154], v2, s[20:23], s46 offen offset:2304 nt
    buffer_load_dwordx3 v[156:158], v2, s[20:23], s46 offen offset:2688 nt
    buffer_load_dwordx3 v[160:162], v2, s[20:23], s47 offen offset:0 nt
    buffer_load_dwordx3 v[164:166], v2, s[20:23], s47 offen offset:384 nt
    buffer_load_dwordx3 v[168:170], v2, s[20:23], s47 offen offset:768 nt
    buffer_load_dwordx3 v[172:174], v2, s[20:23], s47 offen offset:1152 nt
    buffer_load_dwordx3 v[176:178], v2, s[20:23], s47 offen offset:1536 nt
    buffer_load_dwordx3 v[180:182], v2, s[20:23], s47 offen offset:1920 nt
    buffer_load_dwordx3 v[184:186], v2, s[20:23], s47 offen offset:2304 nt
    buffer_load_dwordx3 v[188:190], v2, s[20:23], s47 offen offset:2688 nt
    buffer_load_dwordx3 v[192:194], v2, s[20:23], s48 offen offset:0 nt
    buffer_load_dwordx3 v[196:198], v2, s[20:23], s48 offen offset:384 nt
    buffer_load_dwordx3 v[200:202], v2, s[20:23], s48 offen offset:768 nt
    buffer_load_dwordx3 v[204:206], v2, s[20:23], s48 offen offset:1152 nt
    buffer_load_dwordx3 v[208:210], v2, s[20:23], s48 offen offset:1536 nt
    buffer_load_dwordx3 v[212:214], v2, s[20:23], s48 offen offset:1920 nt
    buffer_load_dwordx3 v[216:218], v2, s[20:23], s48 offen offset:2304 nt
    buffer_load_dwordx3 v[220:222], v2, s[20:23], s48 offen offset:2688 nt
    buffer_load_dwordx3 v[224:226], v2, s[20:23], s49 offen offset:0 nt
    buffer_load_dwordx3 v[228:230], v2, s[20:23], s49 offen offset:384 nt
    buffer_load_dwordx3 v[232:234], v2, s[20:23], s49 offen offset:768 nt
    buffer_load_dwordx3 v[236:238], v2, s[20:23], s49 offen offset:1152 nt
    buffer_load_dwordx3 v[240:242], v2, s[20:23], s49 offen offset:1536 nt
    buffer_load_dwordx3 v[244:246], v2, s[20:23], s49 offen offset:1920 nt
    buffer_load_dwordx3 v[248:250], v2, s[20:23], s49 offen offset:2304 nt
    buffer_load_dwordx3 v[252:254], v2, s[20:23], s49 offen offset:2688 nt
    s_setprio 0
    s_mul_i32 s52, s45, 98304
    s_mul_i32 s55, s44, 12288
    s_add_u32 s28, s4, s52
    s_addc_u32 s29, s5, 0
    s_mov_b32 s30, 98304
    s_mov_b32 s31, 0x20000
    s_add_u32 s32, s14, s52
    s_addc_u32 s33, s15, 0
    s_mov_b32 s34, 98304
    s_mov_b32 s35, 0x20000
    s_and_b32 s60, s45, 0xfc
    s_add_u32 s6, s16, s60
    s_addc_u32 s7, s17, 0
    s_and_b32 s8, s41, 3
    s_lshl_b32 s8, s8, 3
    s_lshl_b32 s9, 1, s8
    v_lshlrev_b32 v4, 8, v6
    v_add_u32 v5, 0, v6
    v_mul_u32_u24 v5, 0x5556, v5
    v_lshrrev_b32 v5, 16, v5
    v_xor_b32 v5, v5, v7
    v_lshl_add_u32 v72, v5, 4, v4
    v_add_u32 v5, 4, v6
    v_mul_u32_u24 v5, 0x5556, v5
    v_lshrrev_b32 v5, 16, v5
    v_xor_b32 v5, v5, v7
    v_lshl_add_u32 v73, v5, 4, v4
    v_add_u32 v5, 8, v6
    v_mul_u32_u24 v5, 0x5556, v5
    v_lshrrev_b32 v5, 16, v5
    v_xor_b32 v5, v5, v7
    v_lshl_add_u32 v74, v5, 4, v4
    v_add_u32 v5, 12, v6
    v_mul_u32_u24 v5, 0x5556, v5
    v_lshrrev_b32 v5, 16, v5
    v_xor_b32 v5, v5, v7
    v_lshl_add_u32 v75, v5, 4, v4
    v_add_u32 v5, 16, v6
    v_mul_u32_u24 v5, 0x5556, v5
    v_lshrrev_b32 v5, 16, v5
    v_xor_b32 v5, v5, v7
    v_lshl_add_u32 v76, v5, 4, v4
    v_add_u32 v5, 20, v6
    v_mul_u32_u24 v5, 0x5556, v5
    v_lshrrev_b32 v5, 16, v5
    v_xor_b32 v5, v5, v7
    v_lshl_add_u32 v77, v5, 4, v4
    v_add_u32 v5, 24, v6
    v_mul_u32_u24 v5, 0x5556, v5
    v_lshrrev_b32 v5, 16, v5
    v_xor_b32 v5, v5, v7
    v_lshl_add_u32 v78, v5, 4, v4
    v_add_u32 v5, 28, v6
    v_mul_u32_u24 v5, 0x5556, v5
    v_lshrrev_b32 v5, 16, v5
    v_xor_b32 v5, v5, v7
    v_lshl_add_u32 v79, v5, 4, v4
    v_add_u32 v5, 32, v6
    v_mul_u32_u24 v5, 0x5556, v5
    v_lshrrev_b32 v5, 16, v5
    v_xor_b32 v5, v5, v7
    v_lshl_add_u32 v80, v5, 4, v4
    v_add_u32 v5, 36, v6
    v_mul_u32_u24 v5, 0x5556, v5
    v_lshrrev_b32 v5, 16, v5
    v_xor_b32 v5, v5, v7
    v_lshl_add_u32 v81, v5, 4, v4
    v_add_u32 v5, 40, v6
    v_mul_u32_u24 v5, 0x5556, v5
    v_lshrrev_b32 v5, 16, v5
    v_xor_b32 v5, v5, v7
    v_lshl_add_u32 v82, v5, 4, v4
    v_add_u32 v5, 44, v6
    v_mul_u32_u24 v5, 0x5556, v5
    v_lshrrev_b32 v5, 16, v5
    v_xor_b32 v5, v5, v7
    v_lshl_add_u32 v83, v5, 4, v4
    s_mov_b32 s57, 0x05040100
    s_mov_b32 s58, 0x07060302
    s_mul_i32 s59, s44, 6144
    s_add_u32 s59, s59, 98304
    v_add_u32 v100, s59, v85
    s_lshl_b32 s59, s44, 10
    s_add_u32 s60, s59, 98304
    v_add_u32 v101, s60, v85
    s_lshl_b32 s61, s40, 3
    v_mov_b32 v102, s61
    v_mov_b32 v103, 0x7fc00000
    v_lshrrev_b32 v4, 1, v6
    v_mul_u32_u24 v4, 96, v4
    v_mul_u32_u24 v5, 6, v7
    v_add_u32 v4, v4, v5
    v_and_b32 v5, 1, v6
    v_mul_u32_u24 v84, 1600, v5
    v_add_u32 v84, 147456, v84
    v_lshlrev_b32 v5, 3, v5
    v_add_u32 v5, 150656, v5
    v_add_u32 v86, s44, v4
    v_lshl_add_u32 v88, v86, 1, v84
    s_add_u32 s59, s44, 4
    v_add_u32 v86, s59, v4
    v_lshl_add_u32 v89, v86, 1, v84
    s_sub_u32 s59, s44, 2
    v_add_u32 v86, s59, v4
    v_lshrrev_b32 v87, 3, v86
    v_add_u32 v87, v87, v86
    v_lshl_add_u32 v90, v87, 4, v5
    s_add_u32 s59, s44, 2
    v_add_u32 v86, s59, v4
    v_lshrrev_b32 v87, 3, v86
    v_add_u32 v87, v87, v86
    v_lshl_add_u32 v91, v87, 4, v5
    v_and_b32 v4, 7, v7
    v_mul_u32_u24 v4, 400, v4
    v_lshl_add_u32 v4, v6, 4, v4
    v_add_u32 v92, 147456, v4
    v_lshrrev_b32 v4, 1, v6
    v_and_b32 v5, 1, v6
    v_mul_u32_u24 v86, 144, v7
    v_mul_u32_u24 v87, 1152, v4
    v_add_u32 v87, v87, v86
    v_lshl_add_u32 v87, v5, 3, v87
    v_add_u32 v93, 150656, v87
    v_lshrrev_b32 v87, 3, v7
    v_cmp_eq_u32 vcc, v87, v4
    v_mul_u32_u24 v87, 3456, v4
    v_sub_u32 v87, v86, v87
    v_add_u32 v87, 152960, v87
    v_mov_b32 v86, 154112
    v_cndmask_b32 v87, v86, v87, vcc
    v_lshl_add_u32 v94, v5, 3, v87
    v_mul_u32_u24 v4, 768, v7
    v_add_u32 v4, s55, v4
    v_add_u32 v5, 0, v6
    v_xor_b32 v5, v5, v7
    v_lshl_add_u32 v95, v5, 4, v4
    v_add_u32 v5, 4, v6
    v_xor_b32 v5, v5, v7
    v_lshl_add_u32 v96, v5, 4, v4
    v_add_u32 v5, 8, v6
    v_xor_b32 v5, v5, v7
    v_lshl_add_u32 v97, v5, 4, v4
    v_add_u32 v5, 12, v6
    v_xor_b32 v5, v5, v7
    v_lshl_add_u32 v98, v5, 4, v4
    v_lshlrev_b32 v4, 4, v7
    v_mul_u32_u24 v5, 3072, v6
    v_add_u32 v99, v4, v5
    s_mul_i32 s65, s40, 49152
    s_lshl_b32 s59, s44, 10
    s_add_u32 s10, s65, s59
    s_add_u32 s11, s10, 4096
    s_add_u32 s12, s10, 22528
    s_cmp_lt_u32 s44, 2
    s_cselect_b32 s11, s11, s12
    s_add_u32 s12, s10, 26624
    s_add_u32 s13, s64, s59
    s_cmp_lg_u32 s44, 7
    s_cbranch_scc1 L_nozero
    v_mov_b32 v4, 0
    v_mov_b32 v5, 0
    v_lshlrev_b32 v84, 3, v1
    v_add_u32 v84, 154112, v84
    ds_write_b64 v84, v[4:5]
L_nozero:
    s_waitcnt vmcnt(24)
    v_perm_b32 v48, v132, v128, s57
    v_perm_b32 v49, v140, v136, s57
    v_perm_b32 v50, v148, v144, s57
    v_perm_b32 v51, v156, v152, s57
    v_perm_b32 v52, v132, v128, s58
    v_perm_b32 v53, v140, v136, s58
    v_perm_b32 v54, v148, v144, s58
    v_perm_b32 v55, v156, v152, s58
    v_mfma_f32_16x16x32_bf16 v[24:27], v[8:11], v[48:51], 0
    v_perm_b32 v56, v133, v129, s57
    v_perm_b32 v57, v141, v137, s57
    v_perm_b32 v58, v149, v145, s57
    v_perm_b32 v59, v157, v153, s57
    v_mfma_f32_16x16x32_bf16 v[28:31], v[8:11], v[52:55], 0
    v_perm_b32 v60, v133, v129, s58
    v_perm_b32 v61, v141, v137, s58
    v_perm_b32 v62, v149, v145, s58
    v_perm_b32 v63, v157, v153, s58
    v_mfma_f32_16x16x32_bf16 v[32:35], v[8:11], v[56:59], 0
    v_perm_b32 v64, v134, v130, s57
    v_perm_b32 v65, v142, v138, s57
    v_perm_b32 v66, v150, v146, s57
    v_perm_b32 v67, v158, v154, s57
    v_mfma_f32_16x16x32_bf16 v[36:39], v[8:11], v[60:63], 0
    v_perm_b32 v68, v134, v130, s58
    v_perm_b32 v69, v142, v138, s58
    v_perm_b32 v70, v150, v146, s58
    v_perm_b32 v71, v158, v154, s58
    v_mfma_f32_16x16x32_bf16 v[40:43], v[8:11], v[64:67], 0
    s_nop 1
    v_mfma_f32_16x16x32_bf16 v[44:47], v[8:11], v[68:71], 0
    s_waitcnt vmcnt(16)
    v_perm_b32 v48, v164, v160, s57
    v_perm_b32 v49, v172, v168, s57
    v_perm_b32 v50, v180, v176, s57
    v_perm_b32 v51, v188, v184, s57
    v_perm_b32 v52, v164, v160, s58
    v_perm_b32 v53, v172, v168, s58
    v_perm_b32 v54, v180, v176, s58
    v_perm_b32 v55, v188, v184, s58
    v_mfma_f32_16x16x32_bf16 v[24:27], v[12:15], v[48:51], v[24:27]
    v_perm_b32 v56, v165, v161, s57
    v_perm_b32 v57, v173, v169, s57
    v_perm_b32 v58, v181, v177, s57
    v_perm_b32 v59, v189, v185, s57
    v_mfma_f32_16x16x32_bf16 v[28:31], v[12:15], v[52:55], v[28:31]
    v_perm_b32 v60, v165, v161, s58
    v_perm_b32 v61, v173, v169, s58
    v_perm_b32 v62, v181, v177, s58
    v_perm_b32 v63, v189, v185, s58
    v_mfma_f32_16x16x32_bf16 v[32:35], v[12:15], v[56:59], v[32:35]
    v_perm_b32 v64, v166, v162, s57
    v_perm_b32 v65, v174, v170, s57
    v_perm_b32 v66, v182, v178, s57
    v_perm_b32 v67, v190, v186, s57
    v_mfma_f32_16x16x32_bf16 v[36:39], v[12:15], v[60:63], v[36:39]
    v_perm_b32 v68, v166, v162, s58
    v_perm_b32 v69, v174, v170, s58
    v_perm_b32 v70, v182, v178, s58
    v_perm_b32 v71, v190, v186, s58
    v_mfma_f32_16x16x32_bf16 v[40:43], v[12:15], v[64:67], v[40:43]
    s_nop 1
    v_mfma_f32_16x16x32_bf16 v[44:47], v[12:15], v[68:71], v[44:47]
    s_waitcnt vmcnt(8)
    v_perm_b32 v48, v196, v192, s57
    v_perm_b32 v49, v204, v200, s57
    v_perm_b32 v50, v212, v208, s57
    v_perm_b32 v51, v220, v216, s57
    v_perm_b32 v52, v196, v192, s58
    v_perm_b32 v53, v204, v200, s58
    v_perm_b32 v54, v212, v208, s58
    v_perm_b32 v55, v220, v216, s58
    v_mfma_f32_16x16x32_bf16 v[24:27], v[16:19], v[48:51], v[24:27]
    v_perm_b32 v56, v197, v193, s57
    v_perm_b32 v57, v205, v201, s57
    v_perm_b32 v58, v213, v209, s57
    v_perm_b32 v59, v221, v217, s57
    v_mfma_f32_16x16x32_bf16 v[28:31], v[16:19], v[52:55], v[28:31]
    v_perm_b32 v60, v197, v193, s58
    v_perm_b32 v61, v205, v201, s58
    v_perm_b32 v62, v213, v209, s58
    v_perm_b32 v63, v221, v217, s58
    v_mfma_f32_16x16x32_bf16 v[32:35], v[16:19], v[56:59], v[32:35]
    v_perm_b32 v64, v198, v194, s57
    v_perm_b32 v65, v206, v202, s57
    v_perm_b32 v66, v214, v210, s57
    v_perm_b32 v67, v222, v218, s57
    v_mfma_f32_16x16x32_bf16 v[36:39], v[16:19], v[60:63], v[36:39]
    v_perm_b32 v68, v198, v194, s58
    v_perm_b32 v69, v206, v202, s58
    v_perm_b32 v70, v214, v210, s58
    v_perm_b32 v71, v222, v218, s58
    v_mfma_f32_16x16x32_bf16 v[40:43], v[16:19], v[64:67], v[40:43]
    s_nop 1
    v_mfma_f32_16x16x32_bf16 v[44:47], v[16:19], v[68:71], v[44:47]
    s_waitcnt vmcnt(0)
    v_perm_b32 v48, v228, v224, s57
    v_perm_b32 v49, v236, v232, s57
    v_perm_b32 v50, v244, v240, s57
    v_perm_b32 v51, v252, v248, s57
    v_perm_b32 v52, v228, v224, s58
    v_perm_b32 v53, v236, v232, s58
    v_perm_b32 v54, v244, v240, s58
    v_perm_b32 v55, v252, v248, s58
    v_mfma_f32_16x16x32_bf16 v[24:27], v[20:23], v[48:51], v[24:27]
    v_perm_b32 v56, v229, v225, s57
    v_perm_b32 v57, v237, v233, s57
    v_perm_b32 v58, v245, v241, s57
    v_perm_b32 v59, v253, v249, s57
    v_mfma_f32_16x16x32_bf16 v[28:31], v[20:23], v[52:55], v[28:31]
    v_perm_b32 v60, v229, v225, s58
    v_perm_b32 v61, v237, v233, s58
    v_perm_b32 v62, v245, v241, s58
    v_perm_b32 v63, v253, v249, s58
    v_mfma_f32_16x16x32_bf16 v[32:35], v[20:23], v[56:59], v[32:35]
    v_perm_b32 v64, v230, v226, s57
    v_perm_b32 v65, v238, v234, s57
    v_perm_b32 v66, v246, v242, s57
    v_perm_b32 v67, v254, v250, s57
    v_mfma_f32_16x16x32_bf16 v[36:39], v[20:23], v[60:63], v[36:39]
    v_perm_b32 v68, v230, v226, s58
    v_perm_b32 v69, v238, v234, s58
    v_perm_b32 v70, v246, v242, s58
    v_perm_b32 v71, v254, v250, s58
    v_mfma_f32_16x16x32_bf16 v[40:43], v[20:23], v[64:67], v[40:43]
    s_nop 1
    v_mfma_f32_16x16x32_bf16 v[44:47], v[20:23], v[68:71], v[44:47]
    s_cmp_lg_u32 s44, 0
    s_cbranch_scc1 L_noflag
    s_atomic_or s9, s[6:7], 0
L_noflag:
    s_nop 5
    ds_write_b128 v100, v[24:27] offset:0
    ds_write_b128 v100, v[28:31] offset:1024
    ds_write_b128 v100, v[32:35] offset:2048
    ds_write_b128 v100, v[36:39] offset:3072
    ds_write_b128 v100, v[40:43] offset:4096
    ds_write_b128 v100, v[44:47] offset:5120
    s_cmp_ge_u32 s44, 4
    s_cbranch_scc1 L_noq0
    s_add_u32 s56, s55, 0
    s_mov_b32 m0, s56
    s_nop 0
    buffer_load_dwordx4 v72, s[28:31], s56 offen offset:0 nt lds
    buffer_load_dwordx4 v73, s[28:31], s56 offen offset:1024 nt lds
    buffer_load_dwordx4 v74, s[28:31], s56 offen offset:2048 nt lds
    buffer_load_dwordx4 v75, s[28:31], s56 offen offset:3072 nt lds
    s_add_u32 s56, s55, 4096
    s_mov_b32 m0, s56
    s_nop 0
    buffer_load_dwordx4 v76, s[28:31], s56 offen offset:0 nt lds
    buffer_load_dwordx4 v77, s[28:31], s56 offen offset:1024 nt lds
    buffer_load_dwordx4 v78, s[28:31], s56 offen offset:2048 nt lds
    buffer_load_dwordx4 v79, s[28:31], s56 offen offset:3072 nt lds
    s_add_u32 s56, s55, 8192
    s_mov_b32 m0, s56
    s_nop 0
    buffer_load_dwordx4 v80, s[28:31], s56 offen offset:0 nt lds
    buffer_load_dwordx4 v81, s[28:31], s56 offen offset:1024 nt lds
    buffer_load_dwordx4 v82, s[28:31], s56 offen offset:2048 nt lds
    buffer_load_dwordx4 v83, s[28:31], s56 offen offset:3072 nt lds
L_noq0:
    s_waitcnt lgkmcnt(0)
    s_barrier
    s_cmp_ge_u32 s44, 6
    s_cbranch_scc1 L_pubdone
    s_setprio 3
    s_cmp_ge_u32 s44, 4
    s_cbranch_scc1 L_nofl
    global_load_dwordx2 v[104:105], v102, s[16:17] sc1
L_nofl:
    ds_read_b128 v[176:179], v101 offset:0
    ds_read_b128 v[180:183], v101 offset:6144
    ds_read_b128 v[184:187], v101 offset:12288
    ds_read_b128 v[188:191], v101 offset:18432
    ds_read_b128 v[192:195], v101 offset:24576
    ds_read_b128 v[196:199], v101 offset:30720
    ds_read_b128 v[200:203], v101 offset:36864
    ds_read_b128 v[204:207], v101 offset:43008
    s_waitcnt lgkmcnt(0)
    v_add_f32 v176, v176, v180
    v_add_f32 v177, v177, v181
    v_add_f32 v178, v178, v182
    v_add_f32 v179, v179, v183
    v_add_f32 v184, v184, v188
    v_add_f32 v185, v185, v189
    v_add_f32 v186, v186, v190
    v_add_f32 v187, v187, v191
    v_add_f32 v192, v192, v196
    v_add_f32 v193, v193, v197
    v_add_f32 v194, v194, v198
    v_add_f32 v195, v195, v199
    v_add_f32 v200, v200, v204
    v_add_f32 v201, v201, v205
    v_add_f32 v202, v202, v206
    v_add_f32 v203, v203, v207
    v_add_f32 v176, v176, v184
    v_add_f32 v177, v177, v185
    v_add_f32 v178, v178, v186
    v_add_f32 v179, v179, v187
    v_add_f32 v192, v192, v200
    v_add_f32 v193, v193, v201
    v_add_f32 v194, v194, v202
    v_add_f32 v195, v195, v203
    v_add_f32 v176, v176, v192
    v_add_f32 v177, v177, v193
    v_add_f32 v178, v178, v194
    v_add_f32 v179, v179, v195
    v_cmp_eq_u32 s[66:67], -1, v176
    v_cmp_eq_u32 s[68:69], -1, v177
    s_nop 0
    v_cndmask_b32 v176, v176, v103, s[66:67]
    v_cndmask_b32 v177, v177, v103, s[68:69]
    v_cmp_eq_u32 s[66:67], -1, v178
    v_cmp_eq_u32 s[68:69], -1, v179
    s_nop 0
    v_cndmask_b32 v178, v178, v103, s[66:67]
    v_cndmask_b32 v179, v179, v103, s[68:69]
    buffer_store_dwordx4 v[176:179], v85, s[36:39], s13 offen sc1
L_pubdone:
    s_barrier
    s_cmp_ge_u32 s44, 4
    s_cbranch_scc1 L_grpH
    s_mov_b32 s62, 0
    s_waitcnt vmcnt(0)
L_chk:
    v_and_b32 v4, v104, v105
    s_add_u32 s62, s62, 1
    v_readfirstlane_b32 s63, v4
    s_cmp_eq_u32 s63, 0x01010101
    s_cbranch_scc1 L_chk_ok
    s_cmp_gt_u32 s62, 100000
    s_cbranch_scc1 L_chk_ok
    s_sleep 2
    global_load_dwordx2 v[104:105], v102, s[16:17] sc1
    s_waitcnt vmcnt(0)
    s_branch L_chk
L_chk_ok:
    ds_read_b128 v[128:131], v95 offset:0
    ds_read_b128 v[152:155], v97 offset:256
    ds_read_b128 v[132:135], v96 offset:0
    ds_read_b128 v[156:159], v98 offset:256
    ds_read_b128 v[136:139], v97 offset:0
    ds_read_b128 v[160:163], v95 offset:512
    ds_read_b128 v[140:143], v98 offset:0
    ds_read_b128 v[164:167], v96 offset:512
    ds_read_b128 v[144:147], v95 offset:256
    ds_read_b128 v[168:171], v97 offset:512
    ds_read_b128 v[148:151], v96 offset:256
    ds_read_b128 v[172:175], v98 offset:512
    s_mov_b32 s60, s10
    buffer_load_dwordx4 v[208:211], v85, s[36:39], s60 offen sc1
    s_add_u32 s60, s60, 6144
    buffer_load_dwordx4 v[212:215], v85, s[36:39], s60 offen sc1
    s_add_u32 s60, s60, 6144
    buffer_load_dwordx4 v[216:219], v85, s[36:39], s60 offen sc1
    s_add_u32 s60, s60, 6144
    buffer_load_dwordx4 v[220:223], v85, s[36:39], s60 offen sc1
    s_mov_b32 s60, s11
    buffer_load_dwordx4 v[224:227], v85, s[36:39], s60 offen sc1
    s_add_u32 s60, s60, 6144
    buffer_load_dwordx4 v[228:231], v85, s[36:39], s60 offen sc1
    s_add_u32 s60, s60, 6144
    buffer_load_dwordx4 v[232:235], v85, s[36:39], s60 offen sc1
    s_add_u32 s60, s60, 6144
    buffer_load_dwordx4 v[236:239], v85, s[36:39], s60 offen sc1
    s_mov_b32 s60, s12
    buffer_load_dwordx4 v[240:243], v85, s[36:39], s60 offen sc1
    s_add_u32 s60, s60, 6144
    buffer_load_dwordx4 v[244:247], v85, s[36:39], s60 offen sc1
    s_add_u32 s60, s60, 6144
    buffer_load_dwordx4 v[248:251], v85, s[36:39], s60 offen sc1
    s_add_u32 s60, s60, 6144
    buffer_load_dwordx4 v[252:255], v85, s[36:39], s60 offen sc1
    s_barrier
    s_mov_b32 s62, 0
    s_waitcnt vmcnt(0)
L_pchk:
    v_max_u32 v4, v208, v209
    v_max3_u32 v4, v210, v211, v4
    v_max3_u32 v4, v212, v213, v4
    v_max3_u32 v4, v214, v215, v4
    v_max3_u32 v4, v216, v217, v4
    v_max3_u32 v4, v218, v219, v4
    v_max3_u32 v4, v220, v221, v4
    v_max3_u32 v4, v222, v223, v4
    v_max3_u32 v4, v224, v225, v4
    v_max3_u32 v4, v226, v227, v4
    v_max3_u32 v4, v228, v229, v4
    v_max3_u32 v4, v230, v231, v4
    v_max3_u32 v4, v232, v233, v4
    v_max3_u32 v4, v234, v235, v4
    v_max3_u32 v4, v236, v237, v4
    v_max3_u32 v4, v238, v239, v4
    v_max3_u32 v4, v240, v241, v4
    v_max3_u32 v4, v242, v243, v4
    v_max3_u32 v4, v244, v245, v4
    v_max3_u32 v4, v246, v247, v4
    v_max3_u32 v4, v248, v249, v4
    v_max3_u32 v4, v250, v251, v4
    v_max3_u32 v4, v252, v253, v4
    v_max3_u32 v4, v254, v255, v4
    v_cmp_eq_u32 vcc, -1, v4
    s_add_u32 s62, s62, 1
    s_cmp_eq_u64 vcc, 0
    s_cbranch_scc1 L_pok
    s_cmp_gt_u32 s62, 100000
    s_cbranch_scc1 L_pok
    s_sleep 2
    s_mov_b32 s60, s10
    buffer_load_dwordx4 v[208:211], v85, s[36:39], s60 offen sc1
    s_add_u32 s60, s60, 6144
    buffer_load_dwordx4 v[212:215], v85, s[36:39], s60 offen sc1
    s_add_u32 s60, s60, 6144
    buffer_load_dwordx4 v[216:219], v85, s[36:39], s60 offen sc1
    s_add_u32 s60, s60, 6144
    buffer_load_dwordx4 v[220:223], v85, s[36:39], s60 offen sc1
    s_mov_b32 s60, s11
    buffer_load_dwordx4 v[224:227], v85, s[36:39], s60 offen sc1
    s_add_u32 s60, s60, 6144
    buffer_load_dwordx4 v[228:231], v85, s[36:39], s60 offen sc1
    s_add_u32 s60, s60, 6144
    buffer_load_dwordx4 v[232:235], v85, s[36:39], s60 offen sc1
    s_add_u32 s60, s60, 6144
    buffer_load_dwordx4 v[236:239], v85, s[36:39], s60 offen sc1
    s_mov_b32 s60, s12
    buffer_load_dwordx4 v[240:243], v85, s[36:39], s60 offen sc1
    s_add_u32 s60, s60, 6144
    buffer_load_dwordx4 v[244:247], v85, s[36:39], s60 offen sc1
    s_add_u32 s60, s60, 6144
    buffer_load_dwordx4 v[248:251], v85, s[36:39], s60 offen sc1
    s_add_u32 s60, s60, 6144
    buffer_load_dwordx4 v[252:255], v85, s[36:39], s60 offen sc1
    s_waitcnt vmcnt(0)
    s_branch L_pchk
L_pok:
    s_setprio 0
    v_add_f32 v208, v208, v212
    v_add_f32 v216, v216, v220
    v_add_f32 v209, v209, v213
    v_add_f32 v217, v217, v221
    v_add_f32 v210, v210, v214
    v_add_f32 v218, v218, v222
    v_add_f32 v211, v211, v215
    v_add_f32 v219, v219, v223
    v_add_f32 v208, v208, v216
    v_add_f32 v209, v209, v217
    v_add_f32 v210, v210, v218
    v_add_f32 v211, v211, v219
    v_cvt_pk_bf16_f32 v208, v208, v209
    v_cvt_pk_bf16_f32 v209, v210, v211
    v_add_f32 v224, v224, v228
    v_add_f32 v232, v232, v236
    v_add_f32 v225, v225, v229
    v_add_f32 v233, v233, v237
    v_add_f32 v226, v226, v230
    v_add_f32 v234, v234, v238
    v_add_f32 v227, v227, v231
    v_add_f32 v235, v235, v239
    v_add_f32 v224, v224, v232
    v_add_f32 v225, v225, v233
    v_add_f32 v226, v226, v234
    v_add_f32 v227, v227, v235
    v_cvt_pk_bf16_f32 v224, v224, v225
    v_cvt_pk_bf16_f32 v225, v226, v227
    v_add_f32 v240, v240, v244
    v_add_f32 v248, v248, v252
    v_add_f32 v241, v241, v245
    v_add_f32 v249, v249, v253
    v_add_f32 v242, v242, v246
    v_add_f32 v250, v250, v254
    v_add_f32 v243, v243, v247
    v_add_f32 v251, v251, v255
    v_add_f32 v240, v240, v248
    v_add_f32 v241, v241, v249
    v_add_f32 v242, v242, v250
    v_add_f32 v243, v243, v251
    v_cvt_pk_bf16_f32 v240, v240, v241
    v_cvt_pk_bf16_f32 v241, v242, v243
    ds_write_b16 v88, v208 offset:0
    ds_write_b16_d16_hi v88, v208 offset:400
    ds_write_b16 v88, v209 offset:800
    ds_write_b16_d16_hi v88, v209 offset:1200
    ds_write_b64 v91, v[240:241]
    s_cmp_lt_u32 s44, 2
    s_cbranch_scc1 L_c1k
    ds_write_b64 v90, v[224:225]
    s_branch L_pay_done
L_c1k:
    ds_write_b16 v89, v224 offset:0
    ds_write_b16_d16_hi v89, v224 offset:400
    ds_write_b16 v89, v225 offset:800
    ds_write_b16_d16_hi v89, v225 offset:1200
    s_branch L_pay_done
L_grpH:
    s_setprio 0
    s_cmp_ge_u32 s44, 6
    s_cbranch_scc1 L_hfirst
    s_barrier
    s_add_u32 s56, s55, 0
    s_mov_b32 m0, s56
    s_nop 0
    buffer_load_dwordx4 v72, s[28:31], s56 offen offset:0 nt lds
    buffer_load_dwordx4 v73, s[28:31], s56 offen offset:1024 nt lds
    buffer_load_dwordx4 v74, s[28:31], s56 offen offset:2048 nt lds
    buffer_load_dwordx4 v75, s[28:31], s56 offen offset:3072 nt lds
    s_add_u32 s56, s55, 4096
    s_mov_b32 m0, s56
    s_nop 0
    buffer_load_dwordx4 v76, s[28:31], s56 offen offset:0 nt lds
    buffer_load_dwordx4 v77, s[28:31], s56 offen offset:1024 nt lds
    buffer_load_dwordx4 v78, s[28:31], s56 offen offset:2048 nt lds
    buffer_load_dwordx4 v79, s[28:31], s56 offen offset:3072 nt lds
    s_add_u32 s56, s55, 8192
    s_mov_b32 m0, s56
    s_nop 0
    buffer_load_dwordx4 v80, s[28:31], s56 offen offset:0 nt lds
    buffer_load_dwordx4 v81, s[28:31], s56 offen offset:1024 nt lds
    buffer_load_dwordx4 v82, s[28:31], s56 offen offset:2048 nt lds
    buffer_load_dwordx4 v83, s[28:31], s56 offen offset:3072 nt lds
    s_branch L_pay_done
L_hfirst:
    s_add_u32 s56, s55, 0
    s_mov_b32 m0, s56
    s_nop 0
    buffer_load_dwordx4 v72, s[28:31], s56 offen offset:0 nt lds
    buffer_load_dwordx4 v73, s[28:31], s56 offen offset:1024 nt lds
    buffer_load_dwordx4 v74, s[28:31], s56 offen offset:2048 nt lds
    buffer_load_dwordx4 v75, s[28:31], s56 offen offset:3072 nt lds
    s_add_u32 s56, s55, 4096
    s_mov_b32 m0, s56
    s_nop 0
    buffer_load_dwordx4 v76, s[28:31], s56 offen offset:0 nt lds
    buffer_load_dwordx4 v77, s[28:31], s56 offen offset:1024 nt lds
    buffer_load_dwordx4 v78, s[28:31], s56 offen offset:2048 nt lds
    buffer_load_dwordx4 v79, s[28:31], s56 offen offset:3072 nt lds
    s_add_u32 s56, s55, 8192
    s_mov_b32 m0, s56
    s_nop 0
    buffer_load_dwordx4 v80, s[28:31], s56 offen offset:0 nt lds
    buffer_load_dwordx4 v81, s[28:31], s56 offen offset:1024 nt lds
    buffer_load_dwordx4 v82, s[28:31], s56 offen offset:2048 nt lds
    buffer_load_dwordx4 v83, s[28:31], s56 offen offset:3072 nt lds
    s_barrier
    s_waitcnt vmcnt(0)
    ds_read_b128 v[128:131], v95 offset:0
    ds_read_b128 v[152:155], v97 offset:256
    ds_read_b128 v[132:135], v96 offset:0
    ds_read_b128 v[156:159], v98 offset:256
    ds_read_b128 v[136:139], v97 offset:0
    ds_read_b128 v[160:163], v95 offset:512
    ds_read_b128 v[140:143], v98 offset:0
    ds_read_b128 v[164:167], v96 offset:512
    ds_read_b128 v[144:147], v95 offset:256
    ds_read_b128 v[168:171], v97 offset:512
    ds_read_b128 v[148:151], v96 offset:256
    ds_read_b128 v[172:175], v98 offset:512
L_pay_done:
    s_mov_b32 s60, 0x3d93cd3a
    s_mov_b32 s61, 0x3fb8aa3b
    v_cmp_gt_u32 vcc, 32, v1
    s_waitcnt lgkmcnt(0)
    s_barrier
    ds_read_b128 v[8:11], v92 offset:0
    ds_read_b128 v[12:15], v92 offset:64
    ds_read_b128 v[16:19], v92 offset:128
    ds_read_b128 v[20:23], v92 offset:192
    ds_read_b128 v[24:27], v92 offset:256
    ds_read_b128 v[28:31], v92 offset:320
    ds_read_b64 v[32:33], v93 offset:0
    ds_read_b64 v[34:35], v93 offset:16
    ds_read_b64 v[36:37], v93 offset:32
    ds_read_b64 v[38:39], v93 offset:48
    ds_read_b64 v[40:41], v93 offset:64
    ds_read_b64 v[42:43], v93 offset:80
    ds_read_b64 v[44:45], v93 offset:96
    ds_read_b64 v[46:47], v93 offset:112
    s_and_b32 s59, s44, 6
    s_cmp_lg_u32 s59, 4
    s_cbranch_scc1 L_qrd
    s_waitcnt vmcnt(0)
    s_waitcnt lgkmcnt(3)
    ds_read_b128 v[128:131], v95 offset:0
    ds_read_b128 v[152:155], v97 offset:256
    ds_read_b128 v[132:135], v96 offset:0
    ds_read_b128 v[156:159], v98 offset:256
    ds_read_b128 v[136:139], v97 offset:0
    ds_read_b128 v[160:163], v95 offset:512
    ds_read_b128 v[140:143], v98 offset:0
    ds_read_b128 v[164:167], v96 offset:512
    ds_read_b128 v[144:147], v95 offset:256
    ds_read_b128 v[168:171], v97 offset:512
    ds_read_b128 v[148:151], v96 offset:256
    ds_read_b128 v[172:175], v98 offset:512
    s_waitcnt lgkmcnt(10)
    v_mfma_f32_16x16x32_bf16 v[176:179], v[8:11], v[128:131], 0
    v_mfma_f32_16x16x32_bf16 v[180:183], v[8:11], v[152:155], 0
    s_waitcnt lgkmcnt(8)
    v_mfma_f32_16x16x32_bf16 v[176:179], v[12:15], v[132:135], v[176:179]
    v_mfma_f32_16x16x32_bf16 v[180:183], v[12:15], v[156:159], v[180:183]
    s_waitcnt lgkmcnt(6)
    v_mfma_f32_16x16x32_bf16 v[176:179], v[16:19], v[136:139], v[176:179]
    v_mfma_f32_16x16x32_bf16 v[180:183], v[16:19], v[160:163], v[180:183]
    s_waitcnt lgkmcnt(4)
    v_mfma_f32_16x16x32_bf16 v[176:179], v[20:23], v[140:143], v[176:179]
    v_mfma_f32_16x16x32_bf16 v[180:183], v[20:23], v[164:167], v[180:183]
    s_waitcnt lgkmcnt(2)
    v_mfma_f32_16x16x32_bf16 v[176:179], v[24:27], v[144:147], v[176:179]
    v_mfma_f32_16x16x32_bf16 v[180:183], v[24:27], v[168:171], v[180:183]
    s_waitcnt lgkmcnt(0)
    v_mfma_f32_16x16x32_bf16 v[176:179], v[28:31], v[148:151], v[176:179]
    v_mfma_f32_16x16x32_bf16 v[180:183], v[28:31], v[172:175], v[180:183]
    s_branch L_sdone
L_qrd:
    s_waitcnt lgkmcnt(8)
    v_mfma_f32_16x16x32_bf16 v[176:179], v[8:11], v[128:131], 0
    v_mfma_f32_16x16x32_bf16 v[180:183], v[8:11], v[152:155], 0
    v_mfma_f32_16x16x32_bf16 v[176:179], v[12:15], v[132:135], v[176:179]
    v_mfma_f32_16x16x32_bf16 v[180:183], v[12:15], v[156:159], v[180:183]
    v_mfma_f32_16x16x32_bf16 v[176:179], v[16:19], v[136:139], v[176:179]
    v_mfma_f32_16x16x32_bf16 v[180:183], v[16:19], v[160:163], v[180:183]
    v_mfma_f32_16x16x32_bf16 v[176:179], v[20:23], v[140:143], v[176:179]
    v_mfma_f32_16x16x32_bf16 v[180:183], v[20:23], v[164:167], v[180:183]
    v_mfma_f32_16x16x32_bf16 v[176:179], v[24:27], v[144:147], v[176:179]
    v_mfma_f32_16x16x32_bf16 v[180:183], v[24:27], v[168:171], v[180:183]
    v_mfma_f32_16x16x32_bf16 v[176:179], v[28:31], v[148:151], v[176:179]
    v_mfma_f32_16x16x32_bf16 v[180:183], v[28:31], v[172:175], v[180:183]
L_sdone:
    ds_read_b64 v[48:49], v94 offset:0
    ds_read_b64 v[50:51], v94 offset:16
    ds_read_b64 v[52:53], v94 offset:32
    ds_read_b64 v[54:55], v94 offset:48
    ds_read_b64 v[56:57], v94 offset:64
    ds_read_b64 v[58:59], v94 offset:80
    ds_read_b64 v[60:61], v94 offset:96
    ds_read_b64 v[62:63], v94 offset:112
    v_cndmask_b32 v76, v180, v176, vcc
    v_cndmask_b32 v77, v181, v177, vcc
    v_cndmask_b32 v78, v182, v178, vcc
    v_cndmask_b32 v79, v183, v179, vcc
    v_cvt_pk_bf16_f32 v80, v76, v77
    v_cvt_pk_bf16_f32 v81, v78, v79
    v_lshlrev_b32 v76, 16, v80
    v_and_b32 v77, 0xffff0000, v80
    v_lshlrev_b32 v78, 16, v81
    v_and_b32 v79, 0xffff0000, v81
    v_mul_f32 v76, s60, v76
    v_mul_f32 v77, s60, v77
    v_mul_f32 v78, s60, v78
    v_mul_f32 v79, s60, v79
    v_cvt_pk_bf16_f32 v80, v76, v77
    v_cvt_pk_bf16_f32 v81, v78, v79
    v_lshlrev_b32 v76, 16, v80
    v_and_b32 v77, 0xffff0000, v80
    v_lshlrev_b32 v78, 16, v81
    v_and_b32 v79, 0xffff0000, v81
    v_max_f32 v80, v76, v77
    v_max3_f32 v80, v78, v79, v80
    v_mov_b32 v81, v80
    s_nop 1
    v_permlane16_swap_b32 v80, v81
    s_nop 1
    v_max_f32 v80, v80, v81
    v_sub_f32 v76, v76, v80
    v_sub_f32 v77, v77, v80
    v_sub_f32 v78, v78, v80
    v_sub_f32 v79, v79, v80
    v_mul_f32 v76, s61, v76
    v_mul_f32 v77, s61, v77
    v_mul_f32 v78, s61, v78
    v_mul_f32 v79, s61, v79
    v_exp_f32 v76, v76
    v_exp_f32 v77, v77
    v_exp_f32 v78, v78
    v_exp_f32 v79, v79
    s_nop 0
    v_add_f32 v80, v76, v77
    v_add_f32 v81, v78, v79
    v_add_f32 v80, v80, v81
    v_mov_b32 v81, v80
    s_nop 1
    v_permlane16_swap_b32 v80, v81
    s_nop 1
    v_add_f32 v80, v80, v81
    v_rcp_f32 v80, v80
    s_nop 0
    v_mul_f32 v76, v76, v80
    v_mul_f32 v77, v77, v80
    v_mul_f32 v78, v78, v80
    v_mul_f32 v79, v79, v80
    v_cvt_pk_bf16_f32 v82, v76, v77
    v_cvt_pk_bf16_f32 v83, v78, v79
    v_mov_b32 v80, 0
    v_cndmask_b32 v84, v80, v82, vcc
    v_cndmask_b32 v85, v80, v83, vcc
    v_cndmask_b32 v86, v82, v80, vcc
    v_cndmask_b32 v87, v83, v80, vcc
    s_waitcnt lgkmcnt(0)
    s_nop 0
    v_mfma_f32_16x16x16_bf16 v[176:179], v[84:85], v[32:33], 0
    v_mfma_f32_16x16x16_bf16 v[180:183], v[84:85], v[34:35], 0
    v_mfma_f32_16x16x16_bf16 v[184:187], v[84:85], v[36:37], 0
    v_mfma_f32_16x16x16_bf16 v[188:191], v[84:85], v[38:39], 0
    v_mfma_f32_16x16x16_bf16 v[192:195], v[84:85], v[40:41], 0
    v_mfma_f32_16x16x16_bf16 v[196:199], v[84:85], v[42:43], 0
    v_mfma_f32_16x16x16_bf16 v[200:203], v[84:85], v[44:45], 0
    v_mfma_f32_16x16x16_bf16 v[204:207], v[84:85], v[46:47], 0
    v_mfma_f32_16x16x16_bf16 v[208:211], v[82:83], v[48:49], 0
    v_mfma_f32_16x16x16_bf16 v[212:215], v[82:83], v[50:51], 0
    v_mfma_f32_16x16x16_bf16 v[216:219], v[82:83], v[52:53], 0
    v_mfma_f32_16x16x16_bf16 v[220:223], v[82:83], v[54:55], 0
    v_mfma_f32_16x16x16_bf16 v[224:227], v[82:83], v[56:57], 0
    v_mfma_f32_16x16x16_bf16 v[228:231], v[82:83], v[58:59], 0
    v_mfma_f32_16x16x16_bf16 v[232:235], v[82:83], v[60:61], 0
    v_mfma_f32_16x16x16_bf16 v[236:239], v[82:83], v[62:63], 0
    v_cvt_pk_bf16_f32 v104, v176, v180
    v_cvt_pk_bf16_f32 v105, v184, v188
    v_cvt_pk_bf16_f32 v106, v192, v196
    v_cvt_pk_bf16_f32 v107, v200, v204
    buffer_store_dwordx4 v[104:107], v99, s[32:35], s55 offen offset:0 sc1
    v_cvt_pk_bf16_f32 v108, v177, v181
    v_cvt_pk_bf16_f32 v109, v185, v189
    v_cvt_pk_bf16_f32 v110, v193, v197
    v_cvt_pk_bf16_f32 v111, v201, v205
    buffer_store_dwordx4 v[108:111], v99, s[32:35], s55 offen offset:768 sc1
    v_cvt_pk_bf16_f32 v112, v178, v182
    v_cvt_pk_bf16_f32 v113, v186, v190
    v_cvt_pk_bf16_f32 v114, v194, v198
    v_cvt_pk_bf16_f32 v115, v202, v206
    buffer_store_dwordx4 v[112:115], v99, s[32:35], s55 offen offset:1536 sc1
    v_cvt_pk_bf16_f32 v116, v179, v183
    v_cvt_pk_bf16_f32 v117, v187, v191
    v_cvt_pk_bf16_f32 v118, v195, v199
    v_cvt_pk_bf16_f32 v119, v203, v207
    buffer_store_dwordx4 v[116:119], v99, s[32:35], s55 offen offset:2304 sc1
    v_mfma_f32_16x16x16_bf16 v[176:179], v[86:87], v[32:33], 0
    v_mfma_f32_16x16x16_bf16 v[180:183], v[86:87], v[34:35], 0
    v_mfma_f32_16x16x16_bf16 v[184:187], v[86:87], v[36:37], 0
    v_mfma_f32_16x16x16_bf16 v[188:191], v[86:87], v[38:39], 0
    v_mfma_f32_16x16x16_bf16 v[192:195], v[86:87], v[40:41], 0
    v_mfma_f32_16x16x16_bf16 v[196:199], v[86:87], v[42:43], 0
    v_mfma_f32_16x16x16_bf16 v[200:203], v[86:87], v[44:45], 0
    v_mfma_f32_16x16x16_bf16 v[204:207], v[86:87], v[46:47], 0
    v_cvt_pk_bf16_f32 v128, v208, v212
    v_cvt_pk_bf16_f32 v129, v216, v220
    v_cvt_pk_bf16_f32 v130, v224, v228
    v_cvt_pk_bf16_f32 v131, v232, v236
    buffer_store_dwordx4 v[128:131], v99, s[32:35], s55 offen offset:256 sc1
    v_cvt_pk_bf16_f32 v132, v209, v213
    v_cvt_pk_bf16_f32 v133, v217, v221
    v_cvt_pk_bf16_f32 v134, v225, v229
    v_cvt_pk_bf16_f32 v135, v233, v237
    buffer_store_dwordx4 v[132:135], v99, s[32:35], s55 offen offset:1024 sc1
    v_cvt_pk_bf16_f32 v136, v210, v214
    v_cvt_pk_bf16_f32 v137, v218, v222
    v_cvt_pk_bf16_f32 v138, v226, v230
    v_cvt_pk_bf16_f32 v139, v234, v238
    buffer_store_dwordx4 v[136:139], v99, s[32:35], s55 offen offset:1792 sc1
    v_cvt_pk_bf16_f32 v140, v211, v215
    v_cvt_pk_bf16_f32 v141, v219, v223
    v_cvt_pk_bf16_f32 v142, v227, v231
    v_cvt_pk_bf16_f32 v143, v235, v239
    buffer_store_dwordx4 v[140:143], v99, s[32:35], s55 offen offset:2560 sc1
    s_nop 7
    v_cvt_pk_bf16_f32 v144, v176, v180
    v_cvt_pk_bf16_f32 v145, v184, v188
    v_cvt_pk_bf16_f32 v146, v192, v196
    v_cvt_pk_bf16_f32 v147, v200, v204
    buffer_store_dwordx4 v[144:147], v99, s[32:35], s55 offen offset:512 sc1
    v_cvt_pk_bf16_f32 v148, v177, v181
    v_cvt_pk_bf16_f32 v149, v185, v189
    v_cvt_pk_bf16_f32 v150, v193, v197
    v_cvt_pk_bf16_f32 v151, v201, v205
    buffer_store_dwordx4 v[148:151], v99, s[32:35], s55 offen offset:1280 sc1
    v_cvt_pk_bf16_f32 v152, v178, v182
    v_cvt_pk_bf16_f32 v153, v186, v190
    v_cvt_pk_bf16_f32 v154, v194, v198
    v_cvt_pk_bf16_f32 v155, v202, v206
    buffer_store_dwordx4 v[152:155], v99, s[32:35], s55 offen offset:2048 sc1
    v_cvt_pk_bf16_f32 v156, v179, v183
    v_cvt_pk_bf16_f32 v157, v187, v191
    v_cvt_pk_bf16_f32 v158, v195, v199
    v_cvt_pk_bf16_f32 v159, v203, v207
    buffer_store_dwordx4 v[156:159], v99, s[32:35], s55 offen offset:2816 sc1
L_end:
    s_endpgm
.section .rodata,"a"
.p2align 6
.amdhsa_kernel standalone__low_rank_proj_linformer__prompt_kernel
  .amdhsa_next_free_vgpr 256
  .amdhsa_next_free_sgpr 72
  .amdhsa_accum_offset 256
  .amdhsa_group_segment_fixed_size 0
  .amdhsa_kernarg_size 64
  .amdhsa_user_sgpr_count 2
  .amdhsa_user_sgpr_kernarg_segment_ptr 1
  .amdhsa_system_sgpr_workgroup_id_x 1
.end_amdhsa_kernel
```
